```python
import torch

def _softmax(x, axis=-1):
    return torch.softmax(x, dim=axis)
def _gelu(x):
    return torch.nn.functional.gelu(x, approximate="tanh")
def _silu(x):
    return torch.nn.functional.silu(x)
def _sigmoid(x):
    return torch.sigmoid(x)
def _layernorm(x, axis=-1, eps=1e-5):
    m = x.mean(dim=axis, keepdim=True)
    v = x.var(dim=axis, keepdim=True, unbiased=False)
    return (x - m) / torch.sqrt(v + eps)
def _scatter_add(tgt, idx, src, axis=0):
    return tgt.clone().index_add_(axis, idx, src)
def _segment_sum(src, seg, n):
    out = torch.zeros((n,) + src.shape[1:], dtype=src.dtype)
    return out.index_add_(0, seg, src)
def _pad(x, pw):
    flat = tuple(v for pair in reversed(pw) for v in pair)
    return torch.nn.functional.pad(x, flat)

kernel_name = 'standalone__groupnorm__sampling'

def setup_inputs():

    _w = (lambda a: (lambda t: t.to(torch.bfloat16) if t.is_floating_point() else t)(torch.as_tensor(a)))
    B = 16
    G = 32
    cpg = max(1, 512 // G)
    C = G * cpg
    H, W = 32, 32
    return {
        "x": _w(abs((lambda *s: torch.randn(*s, dtype=torch.bfloat16) * 0.05)(B, C, H, W))),
        "g": _w((lambda *s: torch.randn(*s, dtype=torch.bfloat16) * 0.05)(C) + 1.0),
        "b": _w((lambda *s: torch.randn(*s, dtype=torch.bfloat16) * 0.4)(C)),
    }

def reference(x, g, b):
    G = 32
    B, C, H, W = x.shape[0], x.shape[1], x.shape[2], x.shape[3]
    xr = x.reshape(B, G, C // G, H, W)
    mu = xr.mean(axis=(2, 3, 4), keepdims=True)
    var = ((xr - mu) ** 2).mean(axis=(2, 3, 4), keepdims=True)
    xn = (xr - mu) / torch.sqrt(var + 1e-5)
    xn = xn.reshape(B, C, H, W)
    return xn * g[None, :, None, None] + b[None, :, None, None]
```

```asm
; @launch grid=(256,1,1) block=(512,1,1) lds=128
.amdgcn_target "amdgcn-amd-amdhsa--gfx950"
.text
.globl standalone__groupnorm__sampling_kernel
.p2align 8
.type standalone__groupnorm__sampling_kernel,@function
standalone__groupnorm__sampling_kernel:
    s_load_dwordx8 s[4:11], s[0:1], 0
    v_readfirstlane_b32 s3, v0
    s_cmp_ge_u32 s2, 256
    s_cbranch_scc1 L_end
    s_lshr_b32 s3, s3, 6
    s_cmp_eq_u32 s3, 7
    s_cbranch_scc1 L_t2
    s_cmp_eq_u32 s3, 6
    s_cbranch_scc1 L_t1
L_back:
    s_and_b32 s13, s2, 7
    s_mul_i32 s13, s13, 0x120000
    s_bfe_u32 s66, s2, 0x20003
    s_and_b32 s13, s13, 0x460000
    s_mul_i32 s15, s66, 0x8400
    s_and_b32 s12, s2, 0xe0
    s_lshl_b32 s12, s12, 14
    v_lshlrev_b32 v12, 4, v0
    s_or_b32 s12, s12, s13
    s_or_b32 s12, s12, s15
    v_xor_b32 v12, s12, v12
    s_waitcnt lgkmcnt(0)
    global_load_dwordx4 v[36:39], v12, s[4:5]
    s_lshr_b32 s29, s12, 10
    s_and_b32 s29, s29, 0x3e0
    s_and_b32 s12, s12, 0xffff8000
    v_add_u32 v13, 8192, v12
    v_add_u32 v14, 16384, v12
    v_add_u32 v15, 24576, v12
    s_load_dwordx8 s[48:55], s[6:7], s29
    s_load_dwordx8 s[56:63], s[8:9], s29
    s_add_u32 s16, s4, 0x800000
    s_addc_u32 s17, s5, 0
    s_add_u32 s14, s4, s12
    s_addc_u32 s15, s5, 0
    s_load_dwordx2 s[20:21], s[14:15], 0
    s_add_u32 s26, s16, s12
    s_addc_u32 s27, s17, 0
    s_load_dwordx2 s[22:23], s[26:27], 0
    global_load_dwordx4 v[40:43], v13, s[4:5]
    s_add_u32 s18, s10, 0x800000
    s_addc_u32 s19, s11, 0
    s_mov_b32 s28, 0xffff0000
    s_mov_b32 s24, 0x38800000
    s_mov_b32 s25, 0x38800000
    v_and_b32 v1, 7, v0
    v_lshlrev_b32 v1, 3, v1
    v_lshlrev_b32_e64 v2, 3, s3
    s_barrier
    global_load_dwordx4 v[44:47], v14, s[4:5]
    s_barrier
    global_load_dwordx4 v[48:51], v15, s[4:5]
    s_barrier
    global_load_dwordx4 v[52:55], v12, s[16:17]
    s_barrier
    global_load_dwordx4 v[56:59], v13, s[16:17]
    s_barrier
    global_load_dwordx4 v[60:63], v14, s[16:17]
    s_barrier
    global_load_dwordx4 v[64:67], v15, s[16:17]
    s_waitcnt lgkmcnt(0)
    s_lshl_b32 s14, s20, 16
    s_and_b32 s15, s20, s28
    s_lshl_b32 s13, s21, 16
    v_mov_b32 v0, s14
    v_mov_b32 v3, s15
    v_med3_f32 v0, v0, v3, s13
    s_nop 0
    v_readfirstlane_b32 s30, v0
    v_readfirstlane_b32 s31, v0
    s_lshl_b32 s14, s22, 16
    s_and_b32 s15, s22, s28
    s_lshl_b32 s13, s23, 16
    v_mov_b32 v0, s14
    v_mov_b32 v3, s15
    v_med3_f32 v0, v0, v3, s13
    s_nop 0
    v_readfirstlane_b32 s26, v0
    v_readfirstlane_b32 s27, v0
    s_lshr_b32 s13, s3, 1
    s_lshl_b32 s13, s13, 4
    s_and_b32 s14, s66, 6
    s_lshl_b32 s14, s14, 3
    s_xor_b32 s13, s13, s14
    s_lshr_b64 s[14:15], s[48:49], s13
    s_lshl_b32 s32, s14, 16
    s_lshl_b32 s33, s14, 16
    s_lshr_b64 s[14:15], s[56:57], s13
    s_lshl_b32 s34, s14, 16
    s_lshl_b32 s35, s14, 16
    s_lshr_b64 s[14:15], s[50:51], s13
    s_lshl_b32 s36, s14, 16
    s_lshl_b32 s37, s14, 16
    s_lshr_b64 s[14:15], s[58:59], s13
    s_lshl_b32 s38, s14, 16
    s_lshl_b32 s39, s14, 16
    s_lshr_b64 s[14:15], s[52:53], s13
    s_lshl_b32 s40, s14, 16
    s_lshl_b32 s41, s14, 16
    s_lshr_b64 s[14:15], s[60:61], s13
    s_lshl_b32 s42, s14, 16
    s_lshl_b32 s43, s14, 16
    s_lshr_b64 s[14:15], s[54:55], s13
    s_lshl_b32 s44, s14, 16
    s_lshl_b32 s45, s14, 16
    s_lshr_b64 s[14:15], s[62:63], s13
    s_lshl_b32 s46, s14, 16
    s_lshl_b32 s47, s14, 16
    s_waitcnt vmcnt(7)
    v_lshlrev_b32 v68, 16, v36
    v_and_b32 v69, s28, v36
    v_lshlrev_b32 v70, 16, v37
    v_and_b32 v71, s28, v37
    v_lshlrev_b32 v72, 16, v38
    v_and_b32 v73, s28, v38
    v_lshlrev_b32 v74, 16, v39
    v_and_b32 v75, s28, v39
    v_pk_add_f32 v[68:69], v[68:69], s[30:31] neg_lo:[0,1] neg_hi:[0,1]
    v_pk_add_f32 v[70:71], v[70:71], s[30:31] neg_lo:[0,1] neg_hi:[0,1]
    v_pk_add_f32 v[72:73], v[72:73], s[30:31] neg_lo:[0,1] neg_hi:[0,1]
    v_pk_add_f32 v[74:75], v[74:75], s[30:31] neg_lo:[0,1] neg_hi:[0,1]
    v_pk_mul_f32 v[8:9], v[68:69], v[68:69]
    v_pk_mul_f32 v[10:11], v[70:71], v[70:71]
    v_pk_add_f32 v[4:5], v[68:69], v[72:73]
    v_pk_fma_f32 v[8:9], v[72:73], v[72:73], v[8:9]
    v_pk_add_f32 v[6:7], v[70:71], v[74:75]
    v_pk_fma_f32 v[10:11], v[74:75], v[74:75], v[10:11]
    s_waitcnt vmcnt(6)
    v_lshlrev_b32 v76, 16, v40
    v_and_b32 v77, s28, v40
    v_lshlrev_b32 v78, 16, v41
    v_and_b32 v79, s28, v41
    v_lshlrev_b32 v80, 16, v42
    v_and_b32 v81, s28, v42
    v_lshlrev_b32 v82, 16, v43
    v_and_b32 v83, s28, v43
    v_pk_add_f32 v[76:77], v[76:77], s[30:31] neg_lo:[0,1] neg_hi:[0,1]
    v_pk_add_f32 v[78:79], v[78:79], s[30:31] neg_lo:[0,1] neg_hi:[0,1]
    v_pk_add_f32 v[80:81], v[80:81], s[30:31] neg_lo:[0,1] neg_hi:[0,1]
    v_pk_add_f32 v[82:83], v[82:83], s[30:31] neg_lo:[0,1] neg_hi:[0,1]
    v_pk_add_f32 v[4:5], v[4:5], v[76:77]
    v_pk_fma_f32 v[8:9], v[76:77], v[76:77], v[8:9]
    v_pk_add_f32 v[6:7], v[6:7], v[78:79]
    v_pk_fma_f32 v[10:11], v[78:79], v[78:79], v[10:11]
    v_pk_add_f32 v[4:5], v[4:5], v[80:81]
    v_pk_fma_f32 v[8:9], v[80:81], v[80:81], v[8:9]
    v_pk_add_f32 v[6:7], v[6:7], v[82:83]
    v_pk_fma_f32 v[10:11], v[82:83], v[82:83], v[10:11]
    s_waitcnt vmcnt(5)
    v_lshlrev_b32 v84, 16, v44
    v_and_b32 v85, s28, v44
    v_lshlrev_b32 v86, 16, v45
    v_and_b32 v87, s28, v45
    v_lshlrev_b32 v88, 16, v46
    v_and_b32 v89, s28, v46
    v_lshlrev_b32 v90, 16, v47
    v_and_b32 v91, s28, v47
    v_pk_add_f32 v[84:85], v[84:85], s[30:31] neg_lo:[0,1] neg_hi:[0,1]
    v_pk_add_f32 v[86:87], v[86:87], s[30:31] neg_lo:[0,1] neg_hi:[0,1]
    v_pk_add_f32 v[88:89], v[88:89], s[30:31] neg_lo:[0,1] neg_hi:[0,1]
    v_pk_add_f32 v[90:91], v[90:91], s[30:31] neg_lo:[0,1] neg_hi:[0,1]
    v_pk_add_f32 v[4:5], v[4:5], v[84:85]
    v_pk_fma_f32 v[8:9], v[84:85], v[84:85], v[8:9]
    v_pk_add_f32 v[6:7], v[6:7], v[86:87]
    v_pk_fma_f32 v[10:11], v[86:87], v[86:87], v[10:11]
    v_pk_add_f32 v[4:5], v[4:5], v[88:89]
    v_pk_fma_f32 v[8:9], v[88:89], v[88:89], v[8:9]
    v_pk_add_f32 v[6:7], v[6:7], v[90:91]
    v_pk_fma_f32 v[10:11], v[90:91], v[90:91], v[10:11]
    s_waitcnt vmcnt(4)
    v_lshlrev_b32 v92, 16, v48
    v_and_b32 v93, s28, v48
    v_lshlrev_b32 v94, 16, v49
    v_and_b32 v95, s28, v49
    v_lshlrev_b32 v96, 16, v50
    v_and_b32 v97, s28, v50
    v_lshlrev_b32 v98, 16, v51
    v_and_b32 v99, s28, v51
    v_pk_add_f32 v[92:93], v[92:93], s[30:31] neg_lo:[0,1] neg_hi:[0,1]
    v_pk_add_f32 v[94:95], v[94:95], s[30:31] neg_lo:[0,1] neg_hi:[0,1]
    v_pk_add_f32 v[96:97], v[96:97], s[30:31] neg_lo:[0,1] neg_hi:[0,1]
    v_pk_add_f32 v[98:99], v[98:99], s[30:31] neg_lo:[0,1] neg_hi:[0,1]
    v_pk_add_f32 v[4:5], v[4:5], v[92:93]
    v_pk_fma_f32 v[8:9], v[92:93], v[92:93], v[8:9]
    v_pk_add_f32 v[6:7], v[6:7], v[94:95]
    v_pk_fma_f32 v[10:11], v[94:95], v[94:95], v[10:11]
    v_pk_add_f32 v[4:5], v[4:5], v[96:97]
    v_pk_fma_f32 v[8:9], v[96:97], v[96:97], v[8:9]
    v_pk_add_f32 v[6:7], v[6:7], v[98:99]
    v_pk_fma_f32 v[10:11], v[98:99], v[98:99], v[10:11]
    v_pk_add_f32 v[4:5], v[4:5], v[6:7]
    v_pk_add_f32 v[8:9], v[8:9], v[10:11]
    v_add_f32 v4, v4, v5
    v_add_f32 v5, v8, v9
    s_branch L_s1
L_t1:
    s_branch L_back
L_s1:
    s_nop 0
    v_add_f32_dpp v4, v4, v4 row_ror:8 row_mask:0xf bank_mask:0xf
    v_add_f32_dpp v5, v5, v5 row_ror:8 row_mask:0xf bank_mask:0xf
    s_nop 0
    v_add_f32_dpp v4, v4, v4 row_ror:4 row_mask:0xf bank_mask:0xf
    v_add_f32_dpp v5, v5, v5 row_ror:4 row_mask:0xf bank_mask:0xf
    s_nop 0
    v_add_f32_dpp v4, v4, v4 row_ror:2 row_mask:0xf bank_mask:0xf
    v_add_f32_dpp v5, v5, v5 row_ror:2 row_mask:0xf bank_mask:0xf
    s_nop 0
    v_add_f32_dpp v4, v4, v4 row_ror:1 row_mask:0xf bank_mask:0xf
    v_add_f32_dpp v5, v5, v5 row_ror:1 row_mask:0xf bank_mask:0xf
    s_nop 0
    v_add_f32_dpp v4, v4, v4 row_bcast:15 row_mask:0xa bank_mask:0xf
    v_add_f32_dpp v5, v5, v5 row_bcast:15 row_mask:0xa bank_mask:0xf
    s_nop 0
    v_add_f32_dpp v4, v4, v4 row_bcast:31 row_mask:0xc bank_mask:0xf
    v_add_f32_dpp v5, v5, v5 row_bcast:31 row_mask:0xc bank_mask:0xf
    s_mov_b32 exec_lo, 0
    s_mov_b32 exec_hi, 0x80000000
    ds_write_b64 v2, v[4:5] offset:0
    s_mov_b64 exec, -1
    s_waitcnt lgkmcnt(0)
    s_barrier
    ds_read_b64 v[20:21], v1 offset:0
    s_waitcnt lgkmcnt(0)
    s_nop 0
    v_add_f32_dpp v20, v20, v20 row_ror:4 row_mask:0xf bank_mask:0xf
    v_add_f32_dpp v21, v21, v21 row_ror:4 row_mask:0xf bank_mask:0xf
    s_nop 0
    v_add_f32_dpp v20, v20, v20 row_ror:2 row_mask:0xf bank_mask:0xf
    v_add_f32_dpp v21, v21, v21 row_ror:2 row_mask:0xf bank_mask:0xf
    s_nop 0
    v_add_f32_dpp v20, v20, v20 row_ror:1 row_mask:0xf bank_mask:0xf
    v_add_f32_dpp v21, v21, v21 row_ror:1 row_mask:0xf bank_mask:0xf
    v_pk_mul_f32 v[20:21], v[20:21], s[24:25]
    v_add_f32 v16, s30, v20
    v_fma_f32 v21, -v20, v20, v21
    v_cvt_pk_bf16_f32 v16, 0, v16
    v_max_f32 v21, 0, v21
    v_subrev_f32 v6, s30, v16
    v_sub_f32 v20, v20, v6
    v_fma_f32 v20, v20, v20, v21
    v_cvt_pk_bf16_f32 v20, 0, v20
    v_add_f32 v20, 0x3727c5ac, v20
    v_cvt_pk_bf16_f32 v20, 0, v20
    v_sqrt_f32 v20, v20
    v_mov_b32 v7, v6
    v_cvt_pk_bf16_f32 v20, 0, v20
    v_rcp_f32 v4, v20
    v_rcp_f32 v5, v20
    s_nop 0
    v_pk_mul_f32 v[8:9], v[4:5], s[44:45]
    v_pk_fma_f32 v[10:11], v[6:7], v[8:9], s[46:47] neg_lo:[1,0,0] neg_hi:[1,0,0]
    v_pk_fma_f32 v[92:93], v[92:93], v[8:9], v[10:11]
    v_pk_fma_f32 v[94:95], v[94:95], v[8:9], v[10:11]
    v_pk_fma_f32 v[96:97], v[96:97], v[8:9], v[10:11]
    v_pk_fma_f32 v[98:99], v[98:99], v[8:9], v[10:11]
    v_cvt_pk_bf16_f32 v48, v92, v93
    v_cvt_pk_bf16_f32 v49, v94, v95
    v_cvt_pk_bf16_f32 v50, v96, v97
    v_cvt_pk_bf16_f32 v51, v98, v99
    v_pk_mul_f32 v[8:9], v[4:5], s[40:41]
    v_pk_fma_f32 v[10:11], v[6:7], v[8:9], s[42:43] neg_lo:[1,0,0] neg_hi:[1,0,0]
    v_pk_fma_f32 v[84:85], v[84:85], v[8:9], v[10:11]
    v_pk_fma_f32 v[86:87], v[86:87], v[8:9], v[10:11]
    v_pk_fma_f32 v[88:89], v[88:89], v[8:9], v[10:11]
    v_pk_fma_f32 v[90:91], v[90:91], v[8:9], v[10:11]
    v_cvt_pk_bf16_f32 v44, v84, v85
    v_cvt_pk_bf16_f32 v45, v86, v87
    v_cvt_pk_bf16_f32 v46, v88, v89
    v_cvt_pk_bf16_f32 v47, v90, v91
    v_pk_mul_f32 v[8:9], v[4:5], s[36:37]
    v_pk_fma_f32 v[10:11], v[6:7], v[8:9], s[38:39] neg_lo:[1,0,0] neg_hi:[1,0,0]
    v_pk_fma_f32 v[76:77], v[76:77], v[8:9], v[10:11]
    v_pk_fma_f32 v[78:79], v[78:79], v[8:9], v[10:11]
    v_pk_fma_f32 v[80:81], v[80:81], v[8:9], v[10:11]
    v_pk_fma_f32 v[82:83], v[82:83], v[8:9], v[10:11]
    v_cvt_pk_bf16_f32 v40, v76, v77
    v_cvt_pk_bf16_f32 v41, v78, v79
    v_cvt_pk_bf16_f32 v42, v80, v81
    v_cvt_pk_bf16_f32 v43, v82, v83
    v_pk_mul_f32 v[8:9], v[4:5], s[32:33]
    v_pk_fma_f32 v[10:11], v[6:7], v[8:9], s[34:35] neg_lo:[1,0,0] neg_hi:[1,0,0]
    v_pk_fma_f32 v[68:69], v[68:69], v[8:9], v[10:11]
    v_pk_fma_f32 v[70:71], v[70:71], v[8:9], v[10:11]
    v_pk_fma_f32 v[72:73], v[72:73], v[8:9], v[10:11]
    v_pk_fma_f32 v[74:75], v[74:75], v[8:9], v[10:11]
    v_cvt_pk_bf16_f32 v36, v68, v69
    v_cvt_pk_bf16_f32 v37, v70, v71
    v_cvt_pk_bf16_f32 v38, v72, v73
    v_cvt_pk_bf16_f32 v39, v74, v75
    s_waitcnt vmcnt(3)
    v_lshlrev_b32_e64 v68, 16, v52
    v_and_b32_e64 v69, s28, v52
    v_lshlrev_b32_e64 v70, 16, v53
    v_and_b32_e64 v71, s28, v53
    v_lshlrev_b32_e64 v72, 16, v54
    v_and_b32_e64 v73, s28, v54
    v_lshlrev_b32_e64 v74, 16, v55
    v_and_b32_e64 v75, s28, v55
    v_pk_add_f32 v[68:69], v[68:69], s[26:27] neg_lo:[0,1] neg_hi:[0,1]
    v_pk_add_f32 v[70:71], v[70:71], s[26:27] neg_lo:[0,1] neg_hi:[0,1]
    v_pk_add_f32 v[72:73], v[72:73], s[26:27] neg_lo:[0,1] neg_hi:[0,1]
    v_pk_add_f32 v[74:75], v[74:75], s[26:27] neg_lo:[0,1] neg_hi:[0,1]
    v_pk_mul_f32 v[8:9], v[68:69], v[68:69]
    v_pk_mul_f32 v[10:11], v[70:71], v[70:71]
    v_pk_add_f32 v[4:5], v[68:69], v[72:73]
    v_pk_fma_f32 v[8:9], v[72:73], v[72:73], v[8:9]
    v_pk_add_f32 v[6:7], v[70:71], v[74:75]
    v_pk_fma_f32 v[10:11], v[74:75], v[74:75], v[10:11]
    s_waitcnt vmcnt(2)
    global_store_dwordx4 v15, v[48:51], s[10:11] sc1 nt
    v_lshlrev_b32 v76, 16, v56
    v_and_b32 v77, s28, v56
    v_lshlrev_b32 v78, 16, v57
    v_and_b32 v79, s28, v57
    v_lshlrev_b32 v80, 16, v58
    v_and_b32 v81, s28, v58
    v_lshlrev_b32 v82, 16, v59
    v_and_b32 v83, s28, v59
    v_pk_add_f32 v[76:77], v[76:77], s[26:27] neg_lo:[0,1] neg_hi:[0,1]
    v_pk_add_f32 v[78:79], v[78:79], s[26:27] neg_lo:[0,1] neg_hi:[0,1]
    v_pk_add_f32 v[80:81], v[80:81], s[26:27] neg_lo:[0,1] neg_hi:[0,1]
    v_pk_add_f32 v[82:83], v[82:83], s[26:27] neg_lo:[0,1] neg_hi:[0,1]
    v_pk_add_f32 v[4:5], v[4:5], v[76:77]
    v_pk_fma_f32 v[8:9], v[76:77], v[76:77], v[8:9]
    v_pk_add_f32 v[6:7], v[6:7], v[78:79]
    v_pk_fma_f32 v[10:11], v[78:79], v[78:79], v[10:11]
    v_pk_add_f32 v[4:5], v[4:5], v[80:81]
    v_pk_fma_f32 v[8:9], v[80:81], v[80:81], v[8:9]
    v_pk_add_f32 v[6:7], v[6:7], v[82:83]
    v_pk_fma_f32 v[10:11], v[82:83], v[82:83], v[10:11]
    s_waitcnt vmcnt(2)
    global_store_dwordx4 v14, v[44:47], s[10:11] sc1 nt
    v_lshlrev_b32 v84, 16, v60
    v_and_b32 v85, s28, v60
    v_lshlrev_b32 v86, 16, v61
    v_and_b32 v87, s28, v61
    v_lshlrev_b32 v88, 16, v62
    v_and_b32 v89, s28, v62
    v_lshlrev_b32 v90, 16, v63
    v_and_b32 v91, s28, v63
    v_pk_add_f32 v[84:85], v[84:85], s[26:27] neg_lo:[0,1] neg_hi:[0,1]
    v_pk_add_f32 v[86:87], v[86:87], s[26:27] neg_lo:[0,1] neg_hi:[0,1]
    v_pk_add_f32 v[88:89], v[88:89], s[26:27] neg_lo:[0,1] neg_hi:[0,1]
    v_pk_add_f32 v[90:91], v[90:91], s[26:27] neg_lo:[0,1] neg_hi:[0,1]
    v_pk_add_f32 v[4:5], v[4:5], v[84:85]
    v_pk_fma_f32 v[8:9], v[84:85], v[84:85], v[8:9]
    v_pk_add_f32 v[6:7], v[6:7], v[86:87]
    v_pk_fma_f32 v[10:11], v[86:87], v[86:87], v[10:11]
    v_pk_add_f32 v[4:5], v[4:5], v[88:89]
    v_pk_fma_f32 v[8:9], v[88:89], v[88:89], v[8:9]
    v_pk_add_f32 v[6:7], v[6:7], v[90:91]
    v_pk_fma_f32 v[10:11], v[90:91], v[90:91], v[10:11]
    s_branch L_s2
L_t2:
    s_branch L_back
L_s2:
    s_waitcnt vmcnt(2)
    global_store_dwordx4 v13, v[40:43], s[10:11] sc1 nt
    global_store_dwordx4 v12, v[36:39], s[10:11] sc1 nt
    v_lshlrev_b32 v92, 16, v64
    v_and_b32 v93, s28, v64
    v_lshlrev_b32 v94, 16, v65
    v_and_b32 v95, s28, v65
    v_lshlrev_b32 v96, 16, v66
    v_and_b32 v97, s28, v66
    v_lshlrev_b32 v98, 16, v67
    v_and_b32 v99, s28, v67
    v_pk_add_f32 v[92:93], v[92:93], s[26:27] neg_lo:[0,1] neg_hi:[0,1]
    v_pk_add_f32 v[94:95], v[94:95], s[26:27] neg_lo:[0,1] neg_hi:[0,1]
    v_pk_add_f32 v[96:97], v[96:97], s[26:27] neg_lo:[0,1] neg_hi:[0,1]
    v_pk_add_f32 v[98:99], v[98:99], s[26:27] neg_lo:[0,1] neg_hi:[0,1]
    v_pk_add_f32 v[4:5], v[4:5], v[92:93]
    v_pk_fma_f32 v[8:9], v[92:93], v[92:93], v[8:9]
    v_pk_add_f32 v[6:7], v[6:7], v[94:95]
    v_pk_fma_f32 v[10:11], v[94:95], v[94:95], v[10:11]
    v_pk_add_f32 v[4:5], v[4:5], v[96:97]
    v_pk_fma_f32 v[8:9], v[96:97], v[96:97], v[8:9]
    v_pk_add_f32 v[6:7], v[6:7], v[98:99]
    v_pk_fma_f32 v[10:11], v[98:99], v[98:99], v[10:11]
    v_pk_add_f32 v[4:5], v[4:5], v[6:7]
    v_pk_add_f32 v[8:9], v[8:9], v[10:11]
    v_add_f32 v4, v4, v5
    v_add_f32 v5, v8, v9
    s_nop 0
    v_add_f32_dpp v4, v4, v4 row_ror:8 row_mask:0xf bank_mask:0xf
    v_add_f32_dpp v5, v5, v5 row_ror:8 row_mask:0xf bank_mask:0xf
    s_nop 0
    v_add_f32_dpp v4, v4, v4 row_ror:4 row_mask:0xf bank_mask:0xf
    v_add_f32_dpp v5, v5, v5 row_ror:4 row_mask:0xf bank_mask:0xf
    s_nop 0
    v_add_f32_dpp v4, v4, v4 row_ror:2 row_mask:0xf bank_mask:0xf
    v_add_f32_dpp v5, v5, v5 row_ror:2 row_mask:0xf bank_mask:0xf
    s_nop 0
    v_add_f32_dpp v4, v4, v4 row_ror:1 row_mask:0xf bank_mask:0xf
    v_add_f32_dpp v5, v5, v5 row_ror:1 row_mask:0xf bank_mask:0xf
    s_nop 0
    v_add_f32_dpp v4, v4, v4 row_bcast:15 row_mask:0xa bank_mask:0xf
    v_add_f32_dpp v5, v5, v5 row_bcast:15 row_mask:0xa bank_mask:0xf
    s_nop 0
    v_add_f32_dpp v4, v4, v4 row_bcast:31 row_mask:0xc bank_mask:0xf
    v_add_f32_dpp v5, v5, v5 row_bcast:31 row_mask:0xc bank_mask:0xf
    s_mov_b32 exec_lo, 0
    s_mov_b32 exec_hi, 0x80000000
    ds_write_b64 v2, v[4:5] offset:64
    s_mov_b64 exec, -1
    s_waitcnt lgkmcnt(0)
    s_barrier
    ds_read_b64 v[20:21], v1 offset:64
    s_waitcnt lgkmcnt(0)
    s_nop 0
    v_add_f32_dpp v20, v20, v20 row_ror:4 row_mask:0xf bank_mask:0xf
    v_add_f32_dpp v21, v21, v21 row_ror:4 row_mask:0xf bank_mask:0xf
    s_nop 0
    v_add_f32_dpp v20, v20, v20 row_ror:2 row_mask:0xf bank_mask:0xf
    v_add_f32_dpp v21, v21, v21 row_ror:2 row_mask:0xf bank_mask:0xf
    s_nop 0
    v_add_f32_dpp v20, v20, v20 row_ror:1 row_mask:0xf bank_mask:0xf
    v_add_f32_dpp v21, v21, v21 row_ror:1 row_mask:0xf bank_mask:0xf
    v_pk_mul_f32 v[20:21], v[20:21], s[24:25]
    v_add_f32 v16, s26, v20
    v_fma_f32 v21, -v20, v20, v21
    v_cvt_pk_bf16_f32 v16, 0, v16
    v_max_f32 v21, 0, v21
    v_subrev_f32 v6, s26, v16
    v_sub_f32 v20, v20, v6
    v_fma_f32 v20, v20, v20, v21
    v_cvt_pk_bf16_f32 v20, 0, v20
    v_add_f32 v20, 0x3727c5ac, v20
    v_cvt_pk_bf16_f32 v20, 0, v20
    v_sqrt_f32 v20, v20
    v_mov_b32 v7, v6
    v_cvt_pk_bf16_f32 v20, 0, v20
    v_rcp_f32 v4, v20
    v_rcp_f32 v5, v20
    s_nop 0
    v_pk_mul_f32 v[8:9], v[4:5], s[44:45]
    v_pk_fma_f32 v[10:11], v[6:7], v[8:9], s[46:47] neg_lo:[1,0,0] neg_hi:[1,0,0]
    v_pk_fma_f32 v[92:93], v[92:93], v[8:9], v[10:11]
    v_pk_fma_f32 v[94:95], v[94:95], v[8:9], v[10:11]
    v_pk_fma_f32 v[96:97], v[96:97], v[8:9], v[10:11]
    v_pk_fma_f32 v[98:99], v[98:99], v[8:9], v[10:11]
    v_cvt_pk_bf16_f32 v64, v92, v93
    v_cvt_pk_bf16_f32 v65, v94, v95
    v_cvt_pk_bf16_f32 v66, v96, v97
    v_cvt_pk_bf16_f32 v67, v98, v99
    global_store_dwordx4 v15, v[64:67], s[18:19] sc1 nt
    v_pk_mul_f32 v[8:9], v[4:5], s[40:41]
    v_pk_fma_f32 v[10:11], v[6:7], v[8:9], s[42:43] neg_lo:[1,0,0] neg_hi:[1,0,0]
    v_pk_fma_f32 v[84:85], v[84:85], v[8:9], v[10:11]
    v_pk_fma_f32 v[86:87], v[86:87], v[8:9], v[10:11]
    v_pk_fma_f32 v[88:89], v[88:89], v[8:9], v[10:11]
    v_pk_fma_f32 v[90:91], v[90:91], v[8:9], v[10:11]
    v_cvt_pk_bf16_f32 v60, v84, v85
    v_cvt_pk_bf16_f32 v61, v86, v87
    v_cvt_pk_bf16_f32 v62, v88, v89
    v_cvt_pk_bf16_f32 v63, v90, v91
    global_store_dwordx4 v14, v[60:63], s[18:19] sc1 nt
    v_pk_mul_f32 v[8:9], v[4:5], s[36:37]
    v_pk_fma_f32 v[10:11], v[6:7], v[8:9], s[38:39] neg_lo:[1,0,0] neg_hi:[1,0,0]
    v_pk_fma_f32 v[76:77], v[76:77], v[8:9], v[10:11]
    v_pk_fma_f32 v[78:79], v[78:79], v[8:9], v[10:11]
    v_pk_fma_f32 v[80:81], v[80:81], v[8:9], v[10:11]
    v_pk_fma_f32 v[82:83], v[82:83], v[8:9], v[10:11]
    v_cvt_pk_bf16_f32 v56, v76, v77
    v_cvt_pk_bf16_f32 v57, v78, v79
    v_cvt_pk_bf16_f32 v58, v80, v81
    v_cvt_pk_bf16_f32 v59, v82, v83
    global_store_dwordx4 v13, v[56:59], s[18:19] sc1 nt
    v_pk_mul_f32 v[8:9], v[4:5], s[32:33]
    v_pk_fma_f32 v[10:11], v[6:7], v[8:9], s[34:35] neg_lo:[1,0,0] neg_hi:[1,0,0]
    v_pk_fma_f32 v[68:69], v[68:69], v[8:9], v[10:11]
    v_pk_fma_f32 v[70:71], v[70:71], v[8:9], v[10:11]
    v_pk_fma_f32 v[72:73], v[72:73], v[8:9], v[10:11]
    v_pk_fma_f32 v[74:75], v[74:75], v[8:9], v[10:11]
    v_cvt_pk_bf16_f32 v52, v68, v69
    v_cvt_pk_bf16_f32 v53, v70, v71
    v_cvt_pk_bf16_f32 v54, v72, v73
    v_cvt_pk_bf16_f32 v55, v74, v75
    global_store_dwordx4 v12, v[52:55], s[18:19] sc1 nt
L_end:
    s_endpgm
.section .rodata,"a"
.p2align 6
.amdhsa_kernel standalone__groupnorm__sampling_kernel
  .amdhsa_next_free_vgpr 136
  .amdhsa_next_free_sgpr 72
  .amdhsa_accum_offset 136
  .amdhsa_group_segment_fixed_size 0
  .amdhsa_kernarg_size 48
  .amdhsa_user_sgpr_count 2
  .amdhsa_user_sgpr_kernarg_segment_ptr 1
  .amdhsa_system_sgpr_workgroup_id_x 1
  .amdhsa_float_denorm_mode_32 3
.end_amdhsa_kernel
```
